```python
import torch

def _softmax(x, axis=-1):
    return torch.softmax(x, dim=axis)
def _gelu(x):
    return torch.nn.functional.gelu(x, approximate="tanh")
def _silu(x):
    return torch.nn.functional.silu(x)
def _sigmoid(x):
    return torch.sigmoid(x)
def _layernorm(x, axis=-1, eps=1e-5):
    m = x.mean(dim=axis, keepdim=True)
    v = x.var(dim=axis, keepdim=True, unbiased=False)
    return (x - m) / torch.sqrt(v + eps)
def _scatter_add(tgt, idx, src, axis=0):
    return tgt.clone().index_add_(axis, idx, src)
def _segment_sum(src, seg, n):
    out = torch.zeros((n,) + src.shape[1:], dtype=src.dtype)
    return out.index_add_(0, seg, src)
def _pad(x, pw):
    flat = tuple(v for pair in reversed(pw) for v in pair)
    return torch.nn.functional.pad(x, flat)

kernel_name = 'standalone__low_rank_proj_linformer__sampling'

def setup_inputs():

    _w = (lambda a: (lambda t: t.to(torch.bfloat16) if t.is_floating_point() else t)(torch.as_tensor(a)))
    B, H, Sq, Skv, Dh, R = 8, 32, 16, 4096, 192, 8
    return {
        "q": _w((lambda *s: torch.randn(*s, dtype=torch.bfloat16) * 0.8)(B, H, Sq, Dh)),
        "k": _w((lambda *s: torch.randn(*s, dtype=torch.bfloat16) * 0.8)(B, H, Skv, Dh)),
        "v": _w((lambda *s: torch.randn(*s, dtype=torch.bfloat16) * 0.05)(B, H, Skv, Dh)),
        "e_proj": _w((lambda *s: torch.randn(*s, dtype=torch.bfloat16) * 0.8)(R, Skv) * (Skv ** -0.5)),
        "f_proj": _w((lambda *s: torch.randn(*s, dtype=torch.bfloat16) * 0.05)(R, Skv) * (Skv ** -0.5)),
    }

def reference(q, k, v, e_proj, f_proj):
    B, H, Sq, Dh = q.shape
    kp = torch.einsum("rn,bhnd->bhrd", e_proj, k)
    vp = torch.einsum("rn,bhnd->bhrd", f_proj, v)
    scores = torch.einsum("bhqd,bhrd->bhqr", q, kp) * (Dh ** -0.5)
    p = _softmax(scores, axis=-1)
    o = torch.einsum("bhqr,bhrd->bhqd", p, vp)
    return o
```

```asm
; @launch grid=(256,1,1) block=(320,1,1) lds=84224
.amdgcn_target "amdgcn-amd-amdhsa--gfx950"
.text
.globl standalone__low_rank_proj_linformer__sampling_kernel
.p2align 8
.type standalone__low_rank_proj_linformer__sampling_kernel,@function
standalone__low_rank_proj_linformer__sampling_kernel:
  s_cmp_ge_u32 s2, 256
  s_cbranch_scc1 L_end
  s_mov_b32 s3, s2
  s_load_dwordx8 s[4:11], s[0:1], 0
  s_load_dwordx4 s[12:15], s[0:1], 32
  s_load_dwordx4 s[76:79], s[0:1], 48
  v_and_b32 v24, 63, v0
  v_lshrrev_b32 v25, 6, v0
  v_lshrrev_b32 v26, 4, v24
  v_and_b32 v27, 15, v24
  v_readfirstlane_b32 s36, v25
  v_mul_u32_u24 v32, 3072, v26
  v_lshlrev_b32 v31, 4, v27
  v_mov_b32 v81, 56960
  v_mov_b32 v83, 1
  s_cmp_eq_u32 s36, 4
  s_cbranch_scc1 L_ctrl
  v_add_u32 v1, v32, v31
  v_add_u32 v3, 12416, v1
  v_and_b32 v28, 7, v27
  v_lshrrev_b32 v29, 3, v27
  v_lshlrev_b32 v33, 4, v28
  v_add_u32 v33, v32, v33
  v_mul_u32_u24 v34, 12032, v29
  v_add_u32 v33, v33, v34
  v_add_u32 v2, 256, v33
  v_lshlrev_b32 v33, 13, v28
  v_lshlrev_b32 v34, 6, v29
  v_lshlrev_b32 v30, 4, v26
  v_add3_u32 v4, v33, v34, v30
  s_mul_i32 s46, s2, 1572864
  s_mul_i32 s59, s2, 13
  s_mov_b32 s95, 1
  s_mul_i32 s47, s36, s95
  s_add_u32 s47, s59, s47
  s_and_b32 s47, s47, 63
  s_mul_i32 s38, s47, 24576
  s_lshl_b32 s39, s47, 7
  s_mov_b32 s18, 1572864
  s_mov_b32 s19, 0x00020000
  s_mov_b32 s22, 65536
  s_mov_b32 s23, 0x00020000
  s_waitcnt lgkmcnt(0)
  s_add_u32 s32, s6, s46
  s_addc_u32 s33, s7, 0
  s_and_b32 s33, s33, 0xffff
  s_mov_b32 s16, s32
  s_mov_b32 s17, s33
  s_mov_b32 s20, s10
  s_and_b32 s21, s11, 0xffff
  buffer_load_dwordx4 v[148:151], v2, s[16:19], s38 offen offset:0 nt
  buffer_load_dwordx4 v[152:155], v2, s[16:19], s38 offen offset:384 nt
  buffer_load_dwordx4 v[156:159], v2, s[16:19], s38 offen offset:768 nt
  buffer_load_dwordx4 v[160:163], v2, s[16:19], s38 offen offset:1152 nt
  buffer_load_dwordx4 v[164:167], v2, s[16:19], s38 offen offset:1536 nt
  buffer_load_dwordx4 v[168:171], v2, s[16:19], s38 offen offset:1920 nt
  buffer_load_dwordx4 v[172:175], v2, s[16:19], s38 offen offset:2304 nt
  buffer_load_dwordx4 v[176:179], v2, s[16:19], s38 offen offset:2688 nt
  buffer_load_dwordx4 v[12:15], v4, s[20:23], s39 offen
  buffer_load_dwordx4 v[180:183], v1, s[16:19], s38 offen offset:0 nt
  buffer_load_dwordx4 v[184:187], v1, s[16:19], s38 offen offset:384 nt
  buffer_load_dwordx4 v[188:191], v1, s[16:19], s38 offen offset:768 nt
  buffer_load_dwordx4 v[192:195], v1, s[16:19], s38 offen offset:1152 nt
  buffer_load_dwordx4 v[196:199], v1, s[16:19], s38 offen offset:1536 nt
  buffer_load_dwordx4 v[200:203], v1, s[16:19], s38 offen offset:1920 nt
  buffer_load_dwordx4 v[204:207], v1, s[16:19], s38 offen offset:2304 nt
  buffer_load_dwordx4 v[208:211], v1, s[16:19], s38 offen offset:2688 nt
  buffer_load_dwordx4 v[212:215], v3, s[16:19], s38 offen offset:0 nt
  buffer_load_dwordx4 v[216:219], v3, s[16:19], s38 offen offset:384 nt
  buffer_load_dwordx4 v[220:223], v3, s[16:19], s38 offen offset:768 nt
  buffer_load_dwordx4 v[224:227], v3, s[16:19], s38 offen offset:1152 nt
  buffer_load_dwordx4 v[228:231], v3, s[16:19], s38 offen offset:1536 nt
  buffer_load_dwordx4 v[232:235], v3, s[16:19], s38 offen offset:1920 nt
  buffer_load_dwordx4 v[236:239], v3, s[16:19], s38 offen offset:2304 nt
  buffer_load_dwordx4 v[240:243], v3, s[16:19], s38 offen offset:2688 nt
  s_add_u32 s34, s8, s46
  s_addc_u32 s35, s9, 0
  s_and_b32 s35, s35, 0xffff
  s_and_b32 s11, s11, 0xffff
  s_and_b32 s13, s13, 0xffff
  s_mul_i32 s47, s2, 6144
  s_add_u32 s24, s4, s47
  s_addc_u32 s25, s5, 0
  s_and_b32 s25, s25, 0xffff
  s_mov_b32 s26, 6144
  s_mov_b32 s27, 0x00020000
  s_add_u32 s28, s14, s47
  s_addc_u32 s29, s15, 0
  s_and_b32 s29, s29, 0xffff
  s_mov_b32 s30, 6144
  s_mov_b32 s31, 0x00020000
  s_mov_b32 s40, 0x05040100
  s_mov_b32 s41, 0x07060302
  s_mov_b32 s42, 0x00ff00ff
  s_mov_b32 s43, 0x00ff00ff
  s_mov_b32 s44, 0xff00ff00
  s_mov_b32 s45, 0xff00ff00
  s_mov_b32 s48, 0x00ff00ff
  s_mov_b32 s49, 0xff00ff00
  s_mov_b32 s50, -1
  s_mov_b32 s51, 0
  s_mov_b32 s52, 0
  s_mov_b32 s53, -1
  s_mov_b32 s37, s36
  s_mov_b32 s57, 0
  s_mov_b32 s98, 0
  v_mul_u32_u24 v35, 384, v27
  v_add_u32 v35, v35, v30
  buffer_load_dwordx4 v[56:59], v35, s[24:27], 0 offen offset:0
  buffer_load_dwordx4 v[60:63], v35, s[24:27], 0 offen offset:64
  buffer_load_dwordx4 v[64:67], v35, s[24:27], 0 offen offset:128
  buffer_load_dwordx4 v[68:71], v35, s[24:27], 0 offen offset:192
  buffer_load_dwordx4 v[72:75], v35, s[24:27], 0 offen offset:256
  buffer_load_dwordx4 v[76:79], v35, s[24:27], 0 offen offset:320
  v_lshrrev_b32 v36, 1, v26
  v_and_b32 v37, 1, v26
  v_lshlrev_b32 v38, 1, v25
  v_add_u32 v38, v38, v36
  v_mul_u32_u24 v38, 6656, v38
  v_mul_u32_u24 v39, 3328, v37
  v_add_u32 v38, v38, v39
  v_lshlrev_b32 v40, 7, v36
  v_add3_u32 v5, v38, v40, v31
  v_mul_u32_u24 v40, 384, v36
  v_add_u32 v38, v38, v31
  v_add_u32 v38, 256, v38
  v_sub_u32 v6, v38, v40
  v_lshlrev_b32 v38, 1, v36
  v_add_u32 v38, v38, v29
  v_lshlrev_b32 v38, 4, v38
  v_mul_u32_u24 v40, 416, v28
  v_add3_u32 v7, v38, v40, v39
  v_lshlrev_b32 v38, 4, v36
  v_add_u32 v38, v38, v27
  v_lshlrev_b32 v38, 1, v38
  v_mul_u32_u24 v40, 1600, v37
  v_add_u32 v40, 53248, v40
  v_add_u32 v8, v38, v40
  v_mul_u32_u24 v40, 400, v28
  v_add_u32 v40, 53248, v40
  v_add_u32 v9, v40, v30
  v_mul_u32_u24 v38, 384, v27
  v_mul_u32_u24 v39, 96, v25
  v_lshlrev_b32 v40, 3, v26
  v_add3_u32 v10, v38, v39, v40
  v_mul_u32_u24 v38, 3328, v37
  v_mul_u32_u24 v39, 416, v28
  v_lshlrev_b32 v40, 4, v29
  v_add3_u32 v38, v38, v39, v40
  v_mul_u32_u24 v39, 26624, v36
  v_add_u32 v38, v38, v39
  v_add_u32 v11, 64, v38
  v_lshlrev_b32 v38, 3, v24
  v_add_u32 v82, 56448, v38
  v_mov_b32 v84, 0
  v_mov_b32 v85, 0
  v_mov_b32 v86, 0
  v_mov_b32 v87, 0
  v_mov_b32 v88, 0
  v_mov_b32 v89, 0
  v_mov_b32 v90, 0
  v_mov_b32 v91, 0
  v_mov_b32 v92, 0
  v_mov_b32 v93, 0
  v_mov_b32 v94, 0
  v_mov_b32 v95, 0
  v_mov_b32 v96, 0
  v_mov_b32 v97, 0
  v_mov_b32 v98, 0
  v_mov_b32 v99, 0
  v_mov_b32 v100, 0
  v_mov_b32 v101, 0
  v_mov_b32 v102, 0
  v_mov_b32 v103, 0
  v_mov_b32 v104, 0
  v_mov_b32 v105, 0
  v_mov_b32 v106, 0
  v_mov_b32 v107, 0
  v_mov_b32 v108, 0
  v_mov_b32 v109, 0
  v_mov_b32 v110, 0
  v_mov_b32 v111, 0
  v_mov_b32 v112, 0
  v_mov_b32 v113, 0
  v_mov_b32 v114, 0
  v_mov_b32 v115, 0
  v_mov_b32 v116, 0
  v_mov_b32 v117, 0
  v_mov_b32 v118, 0
  v_mov_b32 v119, 0
  v_mov_b32 v120, 0
  v_mov_b32 v121, 0
  v_mov_b32 v122, 0
  v_mov_b32 v123, 0
  v_mov_b32 v124, 0
  v_mov_b32 v125, 0
  v_mov_b32 v126, 0
  v_mov_b32 v127, 0
  v_mov_b32 v128, 0
  v_mov_b32 v129, 0
  v_mov_b32 v130, 0
  v_mov_b32 v131, 0
  v_mov_b32 v132, 0
  v_mov_b32 v133, 0
  v_mov_b32 v134, 0
  v_mov_b32 v135, 0
  v_mov_b32 v136, 0
  v_mov_b32 v137, 0
  v_mov_b32 v138, 0
  v_mov_b32 v139, 0
  v_mov_b32 v140, 0
  v_mov_b32 v141, 0
  v_mov_b32 v142, 0
  v_mov_b32 v143, 0
  v_mov_b32 v144, 0
  v_mov_b32 v145, 0
  v_mov_b32 v146, 0
  v_mov_b32 v147, 0
  s_barrier
  s_mov_b64 exec, 1
  ds_add_rtn_u32 v80, v81, v83
  s_mov_b64 exec, -1
  ds_read_b32 v244, v81 offset:12
  s_waitcnt vmcnt(22)
  s_waitcnt lgkmcnt(0)
  v_readfirstlane_b32 s56, v80
  v_readfirstlane_b32 s96, v244
  v_cndmask_b32 v16, 0, v12, s[42:43]
  v_cndmask_b32 v20, 0, v12, s[44:45]
  v_cndmask_b32 v17, 0, v13, s[42:43]
  v_cndmask_b32 v21, 0, v13, s[44:45]
  v_cndmask_b32 v18, 0, v14, s[42:43]
  v_cndmask_b32 v22, 0, v14, s[44:45]
  v_cndmask_b32 v19, 0, v15, s[42:43]
  v_cndmask_b32 v23, 0, v15, s[44:45]
  s_cmp_gt_u32 s56, s96
  s_cbranch_scc1 L_stall_f
L_cont_f:
  s_cmp_ge_u32 s56, 64
  s_cselect_b32 s16, s34, s32
  s_cselect_b32 s17, s35, s33
  s_cselect_b32 s20, s12, s10
  s_cselect_b32 s21, s13, s11
  s_cmp_ge_u32 s56, 128
  s_cselect_b32 s18, 0, 1572864
  s_cselect_b32 s22, 0, 65536
  s_mul_i32 s46, s56, s95
  s_add_u32 s46, s46, s59
  s_and_b32 s46, s46, 63
  s_mul_i32 s38, s46, 24576
  s_lshl_b32 s39, s46, 7
  v_perm_b32 v24, v152, v148, s40
  v_perm_b32 v28, v152, v148, s41
  v_perm_b32 v32, v153, v149, s40
  v_perm_b32 v36, v153, v149, s41
  v_perm_b32 v40, v154, v150, s40
  v_perm_b32 v44, v154, v150, s41
  v_perm_b32 v48, v155, v151, s40
  v_perm_b32 v52, v155, v151, s41
  buffer_load_dwordx4 v[148:151], v2, s[16:19], s38 offen offset:0 nt
  buffer_load_dwordx4 v[152:155], v2, s[16:19], s38 offen offset:384 nt
  v_perm_b32 v25, v160, v156, s40
  v_perm_b32 v29, v160, v156, s41
  v_perm_b32 v33, v161, v157, s40
  v_perm_b32 v37, v161, v157, s41
  v_perm_b32 v41, v162, v158, s40
  v_perm_b32 v45, v162, v158, s41
  v_perm_b32 v49, v163, v159, s40
  v_perm_b32 v53, v163, v159, s41
  buffer_load_dwordx4 v[156:159], v2, s[16:19], s38 offen offset:768 nt
  buffer_load_dwordx4 v[160:163], v2, s[16:19], s38 offen offset:1152 nt
  v_perm_b32 v26, v168, v164, s40
  v_perm_b32 v30, v168, v164, s41
  v_perm_b32 v34, v169, v165, s40
  v_perm_b32 v38, v169, v165, s41
  v_perm_b32 v42, v170, v166, s40
  v_perm_b32 v46, v170, v166, s41
  v_perm_b32 v50, v171, v167, s40
  v_perm_b32 v54, v171, v167, s41
  buffer_load_dwordx4 v[164:167], v2, s[16:19], s38 offen offset:1536 nt
  buffer_load_dwordx4 v[168:171], v2, s[16:19], s38 offen offset:1920 nt
  v_perm_b32 v27, v176, v172, s40
  v_perm_b32 v31, v176, v172, s41
  v_perm_b32 v35, v177, v173, s40
  v_perm_b32 v39, v177, v173, s41
  v_perm_b32 v43, v178, v174, s40
  v_perm_b32 v47, v178, v174, s41
  v_perm_b32 v51, v179, v175, s40
  v_perm_b32 v55, v179, v175, s41
  buffer_load_dwordx4 v[172:175], v2, s[16:19], s38 offen offset:2304 nt
  buffer_load_dwordx4 v[176:179], v2, s[16:19], s38 offen offset:2688 nt
  v_mfma_f32_16x16x32_bf16 v[116:119], v[12:15], v[24:27], v[116:119]
  v_mfma_f32_16x16x32_bf16 v[120:123], v[12:15], v[28:31], v[120:123]
  v_mfma_f32_16x16x32_bf16 v[124:127], v[12:15], v[32:35], v[124:127]
  v_mfma_f32_16x16x32_bf16 v[128:131], v[12:15], v[36:39], v[128:131]
  v_mfma_f32_16x16x32_bf16 v[132:135], v[12:15], v[40:43], v[132:135]
  v_mfma_f32_16x16x32_bf16 v[136:139], v[12:15], v[44:47], v[136:139]
  v_mfma_f32_16x16x32_bf16 v[140:143], v[12:15], v[48:51], v[140:143]
  v_mfma_f32_16x16x32_bf16 v[144:147], v[12:15], v[52:55], v[144:147]
  buffer_load_dwordx4 v[12:15], v4, s[20:23], s39 offen
  s_waitcnt vmcnt(23)
  v_perm_b32 v24, v184, v180, s40
  v_perm_b32 v28, v184, v180, s41
  v_perm_b32 v32, v185, v181, s40
  v_perm_b32 v36, v185, v181, s41
  v_perm_b32 v40, v186, v182, s40
  v_perm_b32 v44, v186, v182, s41
  v_perm_b32 v48, v187, v183, s40
  v_perm_b32 v52, v187, v183, s41
  buffer_load_dwordx4 v[180:183], v1, s[16:19], s38 offen offset:0 nt
  buffer_load_dwordx4 v[184:187], v1, s[16:19], s38 offen offset:384 nt
  v_perm_b32 v25, v192, v188, s40
  v_perm_b32 v29, v192, v188, s41
  v_perm_b32 v33, v193, v189, s40
  v_perm_b32 v37, v193, v189, s41
  v_perm_b32 v41, v194, v190, s40
  v_perm_b32 v45, v194, v190, s41
  v_perm_b32 v49, v195, v191, s40
  v_perm_b32 v53, v195, v191, s41
  buffer_load_dwordx4 v[188:191], v1, s[16:19], s38 offen offset:768 nt
  buffer_load_dwordx4 v[192:195], v1, s[16:19], s38 offen offset:1152 nt
  v_perm_b32 v26, v200, v196, s40
  v_perm_b32 v30, v200, v196, s41
  v_perm_b32 v34, v201, v197, s40
  v_perm_b32 v38, v201, v197, s41
  v_perm_b32 v42, v202, v198, s40
  v_perm_b32 v46, v202, v198, s41
  v_perm_b32 v50, v203, v199, s40
  v_perm_b32 v54, v203, v199, s41
  buffer_load_dwordx4 v[196:199], v1, s[16:19], s38 offen offset:1536 nt
  buffer_load_dwordx4 v[200:203], v1, s[16:19], s38 offen offset:1920 nt
  v_perm_b32 v27, v208, v204, s40
  v_perm_b32 v31, v208, v204, s41
  v_perm_b32 v35, v209, v205, s40
  v_perm_b32 v39, v209, v205, s41
  v_perm_b32 v43, v210, v206, s40
  v_perm_b32 v47, v210, v206, s41
  v_perm_b32 v51, v211, v207, s40
  v_perm_b32 v55, v211, v207, s41
  buffer_load_dwordx4 v[204:207], v1, s[16:19], s38 offen offset:2304 nt
  buffer_load_dwordx4 v[208:211], v1, s[16:19], s38 offen offset:2688 nt
  v_mfma_f32_16x16x32_bf16 v[84:87], v[16:19], v[24:27], v[84:87]
  v_mfma_f32_16x16x32_bf16 v[88:91], v[16:19], v[28:31], v[88:91]
  v_mfma_f32_16x16x32_bf16 v[92:95], v[16:19], v[32:35], v[92:95]
  v_mfma_f32_16x16x32_bf16 v[96:99], v[16:19], v[36:39], v[96:99]
  v_mfma_f32_16x16x32_bf16 v[100:103], v[16:19], v[40:43], v[100:103]
  v_mfma_f32_16x16x32_bf16 v[104:107], v[16:19], v[44:47], v[104:107]
  v_mfma_f32_16x16x32_bf16 v[108:111], v[16:19], v[48:51], v[108:111]
  v_mfma_f32_16x16x32_bf16 v[112:115], v[16:19], v[52:55], v[112:115]
  s_waitcnt vmcnt(23)
  v_perm_b32 v24, v216, v212, s40
  v_perm_b32 v28, v216, v212, s41
  v_perm_b32 v32, v217, v213, s40
  v_perm_b32 v36, v217, v213, s41
  v_perm_b32 v40, v218, v214, s40
  v_perm_b32 v44, v218, v214, s41
  v_perm_b32 v48, v219, v215, s40
  v_perm_b32 v52, v219, v215, s41
  buffer_load_dwordx4 v[212:215], v3, s[16:19], s38 offen offset:0 nt
  buffer_load_dwordx4 v[216:219], v3, s[16:19], s38 offen offset:384 nt
  v_perm_b32 v25, v224, v220, s40
  v_perm_b32 v29, v224, v220, s41
  v_perm_b32 v33, v225, v221, s40
  v_perm_b32 v37, v225, v221, s41
  v_perm_b32 v41, v226, v222, s40
  v_perm_b32 v45, v226, v222, s41
  v_perm_b32 v49, v227, v223, s40
  v_perm_b32 v53, v227, v223, s41
  buffer_load_dwordx4 v[220:223], v3, s[16:19], s38 offen offset:768 nt
  buffer_load_dwordx4 v[224:227], v3, s[16:19], s38 offen offset:1152 nt
  v_perm_b32 v26, v232, v228, s40
  v_perm_b32 v30, v232, v228, s41
  v_perm_b32 v34, v233, v229, s40
  v_perm_b32 v38, v233, v229, s41
  v_perm_b32 v42, v234, v230, s40
  v_perm_b32 v46, v234, v230, s41
  v_perm_b32 v50, v235, v231, s40
  v_perm_b32 v54, v235, v231, s41
  buffer_load_dwordx4 v[228:231], v3, s[16:19], s38 offen offset:1536 nt
  buffer_load_dwordx4 v[232:235], v3, s[16:19], s38 offen offset:1920 nt
  v_perm_b32 v27, v240, v236, s40
  v_perm_b32 v31, v240, v236, s41
  v_perm_b32 v35, v241, v237, s40
  v_perm_b32 v39, v241, v237, s41
  v_perm_b32 v43, v242, v238, s40
  v_perm_b32 v47, v242, v238, s41
  v_perm_b32 v51, v243, v239, s40
  v_perm_b32 v55, v243, v239, s41
  buffer_load_dwordx4 v[236:239], v3, s[16:19], s38 offen offset:2304 nt
  buffer_load_dwordx4 v[240:243], v3, s[16:19], s38 offen offset:2688 nt
  v_mfma_f32_16x16x32_bf16 v[84:87], v[20:23], v[24:27], v[84:87]
  v_mfma_f32_16x16x32_bf16 v[88:91], v[20:23], v[28:31], v[88:91]
  v_mfma_f32_16x16x32_bf16 v[92:95], v[20:23], v[32:35], v[92:95]
  v_mfma_f32_16x16x32_bf16 v[96:99], v[20:23], v[36:39], v[96:99]
  v_mfma_f32_16x16x32_bf16 v[100:103], v[20:23], v[40:43], v[100:103]
  v_mfma_f32_16x16x32_bf16 v[104:107], v[20:23], v[44:47], v[104:107]
  v_mfma_f32_16x16x32_bf16 v[108:111], v[20:23], v[48:51], v[108:111]
  v_mfma_f32_16x16x32_bf16 v[112:115], v[20:23], v[52:55], v[112:115]
  s_mov_b32 s37, s56
  s_cmp_lt_u32 s37, 64
  s_cbranch_scc1 L_loop
  s_cmp_eq_u32 s57, 0
  s_cbranch_scc1 L_dumpK
  s_branch L_chk
L_loop:
  s_mov_b64 exec, 1
  ds_add_rtn_u32 v80, v81, v83
  s_mov_b64 exec, -1
  ds_read_b32 v244, v81 offset:12
  s_waitcnt vmcnt(16)
  s_waitcnt lgkmcnt(0)
  v_readfirstlane_b32 s56, v80
  v_readfirstlane_b32 s96, v244
  v_cndmask_b32 v16, 0, v12, s[42:43]
  v_cndmask_b32 v20, 0, v12, s[44:45]
  v_cndmask_b32 v17, 0, v13, s[42:43]
  v_cndmask_b32 v21, 0, v13, s[44:45]
  v_cndmask_b32 v18, 0, v14, s[42:43]
  v_cndmask_b32 v22, 0, v14, s[44:45]
  v_cndmask_b32 v19, 0, v15, s[42:43]
  v_cndmask_b32 v23, 0, v15, s[44:45]
  s_cmp_ge_u32 s56, 128
  s_cbranch_scc1 L_last
  s_cmp_gt_u32 s56, s96
  s_cbranch_scc1 L_stall_l
L_cont_l:
  s_cmp_ge_u32 s56, 64
  s_cselect_b32 s16, s34, s32
  s_cselect_b32 s17, s35, s33
  s_cselect_b32 s20, s12, s10
  s_cselect_b32 s21, s13, s11
  s_cmp_ge_u32 s56, 128
  s_cselect_b32 s18, 0, 1572864
  s_cselect_b32 s22, 0, 65536
  s_mul_i32 s46, s56, s95
  s_add_u32 s46, s46, s59
  s_and_b32 s46, s46, 63
  s_mul_i32 s38, s46, 24576
  s_lshl_b32 s39, s46, 7
  v_perm_b32 v24, v152, v148, s40
  v_perm_b32 v28, v152, v148, s41
  v_perm_b32 v32, v153, v149, s40
  v_perm_b32 v36, v153, v149, s41
  v_perm_b32 v40, v154, v150, s40
  v_perm_b32 v44, v154, v150, s41
  v_perm_b32 v48, v155, v151, s40
  v_perm_b32 v52, v155, v151, s41
  buffer_load_dwordx4 v[148:151], v2, s[16:19], s38 offen offset:0 nt
  buffer_load_dwordx4 v[152:155], v2, s[16:19], s38 offen offset:384 nt
  v_perm_b32 v25, v160, v156, s40
  v_perm_b32 v29, v160, v156, s41
  v_perm_b32 v33, v161, v157, s40
  v_perm_b32 v37, v161, v157, s41
  v_perm_b32 v41, v162, v158, s40
  v_perm_b32 v45, v162, v158, s41
  v_perm_b32 v49, v163, v159, s40
  v_perm_b32 v53, v163, v159, s41
  buffer_load_dwordx4 v[156:159], v2, s[16:19], s38 offen offset:768 nt
  buffer_load_dwordx4 v[160:163], v2, s[16:19], s38 offen offset:1152 nt
  v_perm_b32 v26, v168, v164, s40
  v_perm_b32 v30, v168, v164, s41
  v_perm_b32 v34, v169, v165, s40
  v_perm_b32 v38, v169, v165, s41
  v_perm_b32 v42, v170, v166, s40
  v_perm_b32 v46, v170, v166, s41
  v_perm_b32 v50, v171, v167, s40
  v_perm_b32 v54, v171, v167, s41
  buffer_load_dwordx4 v[164:167], v2, s[16:19], s38 offen offset:1536 nt
  buffer_load_dwordx4 v[168:171], v2, s[16:19], s38 offen offset:1920 nt
  v_perm_b32 v27, v176, v172, s40
  v_perm_b32 v31, v176, v172, s41
  v_perm_b32 v35, v177, v173, s40
  v_perm_b32 v39, v177, v173, s41
  v_perm_b32 v43, v178, v174, s40
  v_perm_b32 v47, v178, v174, s41
  v_perm_b32 v51, v179, v175, s40
  v_perm_b32 v55, v179, v175, s41
  buffer_load_dwordx4 v[172:175], v2, s[16:19], s38 offen offset:2304 nt
  buffer_load_dwordx4 v[176:179], v2, s[16:19], s38 offen offset:2688 nt
  v_mfma_f32_16x16x32_bf16 v[116:119], v[12:15], v[24:27], v[116:119]
  v_mfma_f32_16x16x32_bf16 v[120:123], v[12:15], v[28:31], v[120:123]
  v_mfma_f32_16x16x32_bf16 v[124:127], v[12:15], v[32:35], v[124:127]
  v_mfma_f32_16x16x32_bf16 v[128:131], v[12:15], v[36:39], v[128:131]
  v_mfma_f32_16x16x32_bf16 v[132:135], v[12:15], v[40:43], v[132:135]
  v_mfma_f32_16x16x32_bf16 v[136:139], v[12:15], v[44:47], v[136:139]
  v_mfma_f32_16x16x32_bf16 v[140:143], v[12:15], v[48:51], v[140:143]
  v_mfma_f32_16x16x32_bf16 v[144:147], v[12:15], v[52:55], v[144:147]
  buffer_load_dwordx4 v[12:15], v4, s[20:23], s39 offen
  s_waitcnt vmcnt(17)
  v_perm_b32 v24, v184, v180, s40
  v_perm_b32 v28, v184, v180, s41
  v_perm_b32 v32, v185, v181, s40
  v_perm_b32 v36, v185, v181, s41
  v_perm_b32 v40, v186, v182, s40
  v_perm_b32 v44, v186, v182, s41
  v_perm_b32 v48, v187, v183, s40
  v_perm_b32 v52, v187, v183, s41
  buffer_load_dwordx4 v[180:183], v1, s[16:19], s38 offen offset:0 nt
  buffer_load_dwordx4 v[184:187], v1, s[16:19], s38 offen offset:384 nt
  v_perm_b32 v25, v192, v188, s40
  v_perm_b32 v29, v192, v188, s41
  v_perm_b32 v33, v193, v189, s40
  v_perm_b32 v37, v193, v189, s41
  v_perm_b32 v41, v194, v190, s40
  v_perm_b32 v45, v194, v190, s41
  v_perm_b32 v49, v195, v191, s40
  v_perm_b32 v53, v195, v191, s41
  buffer_load_dwordx4 v[188:191], v1, s[16:19], s38 offen offset:768 nt
  buffer_load_dwordx4 v[192:195], v1, s[16:19], s38 offen offset:1152 nt
  v_perm_b32 v26, v200, v196, s40
  v_perm_b32 v30, v200, v196, s41
  v_perm_b32 v34, v201, v197, s40
  v_perm_b32 v38, v201, v197, s41
  v_perm_b32 v42, v202, v198, s40
  v_perm_b32 v46, v202, v198, s41
  v_perm_b32 v50, v203, v199, s40
  v_perm_b32 v54, v203, v199, s41
  buffer_load_dwordx4 v[196:199], v1, s[16:19], s38 offen offset:1536 nt
  buffer_load_dwordx4 v[200:203], v1, s[16:19], s38 offen offset:1920 nt
  v_perm_b32 v27, v208, v204, s40
  v_perm_b32 v31, v208, v204, s41
  v_perm_b32 v35, v209, v205, s40
  v_perm_b32 v39, v209, v205, s41
  v_perm_b32 v43, v210, v206, s40
  v_perm_b32 v47, v210, v206, s41
  v_perm_b32 v51, v211, v207, s40
  v_perm_b32 v55, v211, v207, s41
  buffer_load_dwordx4 v[204:207], v1, s[16:19], s38 offen offset:2304 nt
  buffer_load_dwordx4 v[208:211], v1, s[16:19], s38 offen offset:2688 nt
  v_mfma_f32_16x16x32_bf16 v[84:87], v[16:19], v[24:27], v[84:87]
  v_mfma_f32_16x16x32_bf16 v[88:91], v[16:19], v[28:31], v[88:91]
  v_mfma_f32_16x16x32_bf16 v[92:95], v[16:19], v[32:35], v[92:95]
  v_mfma_f32_16x16x32_bf16 v[96:99], v[16:19], v[36:39], v[96:99]
  v_mfma_f32_16x16x32_bf16 v[100:103], v[16:19], v[40:43], v[100:103]
  v_mfma_f32_16x16x32_bf16 v[104:107], v[16:19], v[44:47], v[104:107]
  v_mfma_f32_16x16x32_bf16 v[108:111], v[16:19], v[48:51], v[108:111]
  v_mfma_f32_16x16x32_bf16 v[112:115], v[16:19], v[52:55], v[112:115]
  s_waitcnt vmcnt(17)
  v_perm_b32 v24, v216, v212, s40
  v_perm_b32 v28, v216, v212, s41
  v_perm_b32 v32, v217, v213, s40
  v_perm_b32 v36, v217, v213, s41
  v_perm_b32 v40, v218, v214, s40
  v_perm_b32 v44, v218, v214, s41
  v_perm_b32 v48, v219, v215, s40
  v_perm_b32 v52, v219, v215, s41
  buffer_load_dwordx4 v[212:215], v3, s[16:19], s38 offen offset:0 nt
  buffer_load_dwordx4 v[216:219], v3, s[16:19], s38 offen offset:384 nt
  v_perm_b32 v25, v224, v220, s40
  v_perm_b32 v29, v224, v220, s41
  v_perm_b32 v33, v225, v221, s40
  v_perm_b32 v37, v225, v221, s41
  v_perm_b32 v41, v226, v222, s40
  v_perm_b32 v45, v226, v222, s41
  v_perm_b32 v49, v227, v223, s40
  v_perm_b32 v53, v227, v223, s41
  buffer_load_dwordx4 v[220:223], v3, s[16:19], s38 offen offset:768 nt
  buffer_load_dwordx4 v[224:227], v3, s[16:19], s38 offen offset:1152 nt
  v_perm_b32 v26, v232, v228, s40
  v_perm_b32 v30, v232, v228, s41
  v_perm_b32 v34, v233, v229, s40
  v_perm_b32 v38, v233, v229, s41
  v_perm_b32 v42, v234, v230, s40
  v_perm_b32 v46, v234, v230, s41
  v_perm_b32 v50, v235, v231, s40
  v_perm_b32 v54, v235, v231, s41
  buffer_load_dwordx4 v[228:231], v3, s[16:19], s38 offen offset:1536 nt
  buffer_load_dwordx4 v[232:235], v3, s[16:19], s38 offen offset:1920 nt
  v_perm_b32 v27, v240, v236, s40
  v_perm_b32 v31, v240, v236, s41
  v_perm_b32 v35, v241, v237, s40
  v_perm_b32 v39, v241, v237, s41
  v_perm_b32 v43, v242, v238, s40
  v_perm_b32 v47, v242, v238, s41
  v_perm_b32 v51, v243, v239, s40
  v_perm_b32 v55, v243, v239, s41
  buffer_load_dwordx4 v[236:239], v3, s[16:19], s38 offen offset:2304 nt
  buffer_load_dwordx4 v[240:243], v3, s[16:19], s38 offen offset:2688 nt
  v_mfma_f32_16x16x32_bf16 v[84:87], v[20:23], v[24:27], v[84:87]
  v_mfma_f32_16x16x32_bf16 v[88:91], v[20:23], v[28:31], v[88:91]
  v_mfma_f32_16x16x32_bf16 v[92:95], v[20:23], v[32:35], v[92:95]
  v_mfma_f32_16x16x32_bf16 v[96:99], v[20:23], v[36:39], v[96:99]
  v_mfma_f32_16x16x32_bf16 v[100:103], v[20:23], v[40:43], v[100:103]
  v_mfma_f32_16x16x32_bf16 v[104:107], v[20:23], v[44:47], v[104:107]
  v_mfma_f32_16x16x32_bf16 v[108:111], v[20:23], v[48:51], v[108:111]
  v_mfma_f32_16x16x32_bf16 v[112:115], v[20:23], v[52:55], v[112:115]
  s_mov_b32 s37, s56
  s_cmp_lt_u32 s37, 64
  s_cbranch_scc1 L_loop
  s_cmp_eq_u32 s57, 0
  s_cbranch_scc1 L_dumpK
L_chk:
  s_cmp_lt_u32 s37, 128
  s_cbranch_scc1 L_loop
  s_branch L_tail
L_stall_f:
  s_cmp_ge_u32 s56, 128
  s_cbranch_scc1 L_cont_f
  s_cmp_lg_u32 s98, 0
  s_cbranch_scc1 L_cont_f
  s_mov_b32 s97, 0
L_st_f:
  s_sleep 1
  ds_read_b32 v244, v81 offset:12
  s_waitcnt lgkmcnt(0)
  v_readfirstlane_b32 s96, v244
  s_nop 3
  s_cmp_le_u32 s56, s96
  s_cbranch_scc1 L_cont_f
  s_add_u32 s97, s97, 1
  s_cmp_lt_u32 s97, 4096
  s_cbranch_scc1 L_st_f
  s_mov_b32 s98, 1
  s_branch L_cont_f
L_stall_l:
  s_cmp_ge_u32 s56, 128
  s_cbranch_scc1 L_cont_l
  s_cmp_lg_u32 s98, 0
  s_cbranch_scc1 L_cont_l
  s_mov_b32 s97, 0
L_st_l:
  s_sleep 1
  ds_read_b32 v244, v81 offset:12
  s_waitcnt lgkmcnt(0)
  v_readfirstlane_b32 s96, v244
  s_nop 3
  s_cmp_le_u32 s56, s96
  s_cbranch_scc1 L_cont_l
  s_add_u32 s97, s97, 1
  s_cmp_lt_u32 s97, 4096
  s_cbranch_scc1 L_st_l
  s_mov_b32 s98, 1
  s_branch L_cont_l
L_ctrl:
  v_mov_b32 v38, 4
  v_mov_b32 v39, 0
  v_mov_b32 v40, 0
  v_mov_b32 v41, 255
  v_mov_b32 v42, 0
  v_mov_b32 v43, 0
  ds_write_b128 v81, v[38:41]
  ds_write_b64 v81, v[42:43] offset:16
  s_waitcnt lgkmcnt(0)
  s_barrier
  s_setprio 3
  s_mov_b32 s62, s78
  s_mov_b32 s63, s79
  s_getreg_b32 s84, hwreg(HW_REG_XCC_ID, 0, 4)
  s_and_b32 s84, s84, 7
  s_getreg_b32 s85, hwreg(HW_REG_HW_ID, 8, 8)
  s_memrealtime s[90:91]
  s_mul_i32 s46, s2, 1572864
  s_add_u32 s16, s6, s46
  s_addc_u32 s17, s7, 0
  s_and_b32 s17, s17, 0xffff
  s_mov_b32 s18, 1572864
  s_mov_b32 s19, 0x00020000
  s_add_u32 s20, s8, s46
  s_addc_u32 s21, s9, 0
  s_and_b32 s21, s21, 0xffff
  s_mov_b32 s22, 1572864
  s_mov_b32 s23, 0x00020000
  v_lshlrev_b32 v12, 18, v24
  buffer_load_dword v13, v12, s[20:23], 0 offen nt
  buffer_load_dword v14, v12, s[16:19], 0 offen nt
  s_mov_b32 s86, s85
  s_mov_b32 s87, s84
  s_waitcnt lgkmcnt(0)
  s_lshr_b32 s89, s90, 10
  s_and_b32 s89, s89, 0xffff
  s_lshl_b32 s92, s89, 16
  s_sub_u32 s93, 2, s89
  s_min_u32 s86, s86, 255
  s_mul_i32 s97, s86, 1280
  s_add_u32 s60, s62, 1048576
  s_addc_u32 s61, s63, 0
  s_and_b32 s61, s61, 0xffff
  s_mov_b32 s62, 327680
  s_mov_b32 s63, 0x00020000
  s_mul_i32 s99, s87, 128
  s_add_u32 s99, s99, s97
  v_and_b32 v1, 7, v24
  v_lshlrev_b32 v6, 4, v1
  v_and_b32 v1, 7, v24
  v_mul_u32_u24 v1, 128, v1
  v_lshrrev_b32 v12, 4, v6
  v_lshlrev_b32 v12, 2, v12
  s_mul_i32 s46, s86, 5
  s_lshr_b32 s47, s86, 5
  s_mul_i32 s47, s47, 9
  s_add_u32 s46, s46, s47
  s_and_b32 s46, s46, 31
  s_sub_u32 s100, 32, s46
  s_or_b32 s94, s100, s92
  v_mov_b32 v8, s94
  v_mov_b32 v9, s94
  v_mov_b32 v10, s94
  v_mov_b32 v11, s94
  s_mov_b64 exec, 255
  buffer_store_dwordx4 v[8:11], v6, s[60:63], s99 offen sc1
  s_mov_b64 exec, -1
L_cl:
  ds_read_b32 v2, v81
  s_waitcnt lgkmcnt(0)
  v_readfirstlane_b32 s56, v2
  s_nop 3
  s_cmp_ge_u32 s56, 128
  s_cbranch_scc1 L_cfin
  s_cmp_lt_u32 s56, s100
  s_cbranch_scc1 L_cnopub
  s_cmp_ge_u32 s100, 90
  s_cselect_b32 s46, 8, 32
  s_add_u32 s100, s100, s46
L_cpub:
  s_or_b32 s94, s100, s92
  v_mov_b32 v8, s94
  v_mov_b32 v9, s94
  v_mov_b32 v10, s94
  v_mov_b32 v11, s94
  s_mov_b64 exec, 255
  buffer_store_dwordx4 v[8:11], v6, s[60:63], s99 offen sc1
  s_mov_b64 exec, -1
L_cnopub:
  buffer_load_dword v4, v1, s[60:63], s97 offen sc1
  s_waitcnt vmcnt(0)
  v_lshrrev_b32 v13, 16, v4
  v_add_u32 v13, s93, v13
  v_and_b32 v13, 0xffff, v13
  v_and_b32 v4, 0xffff, v4
  v_cmp_ge_u32 vcc, 4, v13
  v_mov_b32 v14, 255
  s_nop 0
  v_cndmask_b32 v4, v14, v4, vcc
  s_waitcnt vmcnt(0)
  v_readlane_b32 s64, v4, 0
  v_readlane_b32 s65, v4, 1
  v_readlane_b32 s66, v4, 2
  v_readlane_b32 s67, v4, 3
  v_readlane_b32 s68, v4, 4
  v_readlane_b32 s69, v4, 5
  v_readlane_b32 s70, v4, 6
  v_readlane_b32 s71, v4, 7
  s_nop 3
  s_min_u32 s64, s64, s65
  s_min_u32 s64, s64, s66
  s_min_u32 s64, s64, s67
  s_min_u32 s64, s64, s68
  s_min_u32 s64, s64, s69
  s_min_u32 s64, s64, s70
  s_min_u32 s64, s64, s71
  s_min_u32 s64, s64, 250
  s_add_u32 s64, s64, 1
  v_mov_b32 v5, s64
  s_mov_b64 exec, 1
  ds_write_b32 v81, v5 offset:12
  s_mov_b64 exec, -1
  s_sleep 8
  s_branch L_cl
L_cfin:
  s_or_b32 s94, 255, s92
  v_mov_b32 v8, s94
  v_mov_b32 v9, s94
  v_mov_b32 v10, s94
  v_mov_b32 v11, s94
  s_mov_b64 exec, 255
  buffer_store_dwordx4 v[8:11], v6, s[60:63], s99 offen sc1
L_cexit:
  v_mov_b32 v5, 255
  s_mov_b64 exec, 1
  ds_write_b32 v81, v5 offset:12
  s_endpgm
L_dumpK:
  s_mov_b32 s57, 1
  s_nop 7
  s_nop 1
  ds_write_b128 v5, v[84:87] offset:0
  ds_write_b128 v5, v[88:91] offset:416
  ds_write_b128 v5, v[92:95] offset:832
  ds_write_b128 v5, v[96:99] offset:1248
  ds_write_b128 v5, v[100:103] offset:1664
  ds_write_b128 v5, v[104:107] offset:2080
  ds_write_b128 v5, v[108:111] offset:2496
  ds_write_b128 v5, v[112:115] offset:2912
  s_mov_b64 exec, s[48:49]
  ds_write_b128 v6, v[116:119] offset:0
  ds_write_b128 v6, v[120:123] offset:416
  ds_write_b128 v6, v[124:127] offset:832
  ds_write_b128 v6, v[128:131] offset:1248
  ds_write_b128 v6, v[132:135] offset:1664
  ds_write_b128 v6, v[136:139] offset:2080
  ds_write_b128 v6, v[140:143] offset:2496
  ds_write_b128 v6, v[144:147] offset:2912
  s_mov_b64 exec, -1
  s_mov_b64 exec, 1
  ds_add_rtn_u32 v80, v81, v83 offset:4
  s_mov_b64 exec, -1
  v_mov_b32 v84, 0
  v_mov_b32 v85, 0
  v_mov_b32 v86, 0
  v_mov_b32 v87, 0
  v_mov_b32 v88, 0
  v_mov_b32 v89, 0
  v_mov_b32 v90, 0
  v_mov_b32 v91, 0
  v_mov_b32 v92, 0
  v_mov_b32 v93, 0
  v_mov_b32 v94, 0
  v_mov_b32 v95, 0
  v_mov_b32 v96, 0
  v_mov_b32 v97, 0
  v_mov_b32 v98, 0
  v_mov_b32 v99, 0
  v_mov_b32 v100, 0
  v_mov_b32 v101, 0
  v_mov_b32 v102, 0
  v_mov_b32 v103, 0
  v_mov_b32 v104, 0
  v_mov_b32 v105, 0
  v_mov_b32 v106, 0
  v_mov_b32 v107, 0
  v_mov_b32 v108, 0
  v_mov_b32 v109, 0
  v_mov_b32 v110, 0
  v_mov_b32 v111, 0
  v_mov_b32 v112, 0
  v_mov_b32 v113, 0
  v_mov_b32 v114, 0
  v_mov_b32 v115, 0
  v_mov_b32 v116, 0
  v_mov_b32 v117, 0
  v_mov_b32 v118, 0
  v_mov_b32 v119, 0
  v_mov_b32 v120, 0
  v_mov_b32 v121, 0
  v_mov_b32 v122, 0
  v_mov_b32 v123, 0
  v_mov_b32 v124, 0
  v_mov_b32 v125, 0
  v_mov_b32 v126, 0
  v_mov_b32 v127, 0
  v_mov_b32 v128, 0
  v_mov_b32 v129, 0
  v_mov_b32 v130, 0
  v_mov_b32 v131, 0
  v_mov_b32 v132, 0
  v_mov_b32 v133, 0
  v_mov_b32 v134, 0
  v_mov_b32 v135, 0
  v_mov_b32 v136, 0
  v_mov_b32 v137, 0
  v_mov_b32 v138, 0
  v_mov_b32 v139, 0
  v_mov_b32 v140, 0
  v_mov_b32 v141, 0
  v_mov_b32 v142, 0
  v_mov_b32 v143, 0
  v_mov_b32 v144, 0
  v_mov_b32 v145, 0
  v_mov_b32 v146, 0
  v_mov_b32 v147, 0
  s_waitcnt lgkmcnt(0)
  v_readfirstlane_b32 s46, v80
  s_nop 3
  s_cmp_lg_u32 s46, 3
  s_cbranch_scc1 L_chk
  v_mov_b32 v20, v7
  v_mov_b32 v22, v8
  s_mov_b32 s58, 0
L_kred:
  ds_read_b128 v[24:27], v20 offset:0
  ds_read_b128 v[28:31], v20 offset:6656
  ds_read_b128 v[32:35], v20 offset:13312
  ds_read_b128 v[36:39], v20 offset:19968
  ds_read_b128 v[40:43], v20 offset:26624
  ds_read_b128 v[44:47], v20 offset:33280
  ds_read_b128 v[48:51], v20 offset:39936
  ds_read_b128 v[52:55], v20 offset:46592
  s_waitcnt lgkmcnt(7)
  v_mov_b32 v16, v24
  v_mov_b32 v17, v25
  v_mov_b32 v18, v26
  v_mov_b32 v19, v27
  s_waitcnt lgkmcnt(6)
  v_add_f32 v16, v16, v28
  v_add_f32 v17, v17, v29
  v_add_f32 v18, v18, v30
  v_add_f32 v19, v19, v31
  s_waitcnt lgkmcnt(5)
  v_add_f32 v16, v16, v32
  v_add_f32 v17, v17, v33
  v_add_f32 v18, v18, v34
  v_add_f32 v19, v19, v35
  s_waitcnt lgkmcnt(4)
  v_add_f32 v16, v16, v36
  v_add_f32 v17, v17, v37
  v_add_f32 v18, v18, v38
  v_add_f32 v19, v19, v39
  s_waitcnt lgkmcnt(3)
  v_add_f32 v16, v16, v40
  v_add_f32 v17, v17, v41
  v_add_f32 v18, v18, v42
  v_add_f32 v19, v19, v43
  s_waitcnt lgkmcnt(2)
  v_add_f32 v16, v16, v44
  v_add_f32 v17, v17, v45
  v_add_f32 v18, v18, v46
  v_add_f32 v19, v19, v47
  s_waitcnt lgkmcnt(1)
  v_add_f32 v16, v16, v48
  v_add_f32 v17, v17, v49
  v_add_f32 v18, v18, v50
  v_add_f32 v19, v19, v51
  s_waitcnt lgkmcnt(0)
  v_add_f32 v16, v16, v52
  v_add_f32 v17, v17, v53
  v_add_f32 v18, v18, v54
  v_add_f32 v19, v19, v55
  v_cvt_pk_bf16_f32 v24, v16, v17
  v_cvt_pk_bf16_f32 v25, v18, v19
  ds_write_b16 v22, v24 offset:0
  ds_write_b16_d16_hi v22, v24 offset:400
  ds_write_b16 v22, v25 offset:800
  ds_write_b16_d16_hi v22, v25 offset:1200
  v_add_u32 v20, 64, v20
  v_add_u32 v22, 64, v22
  s_add_u32 s58, s58, 1
  s_cmp_lt_u32 s58, 6
  s_waitcnt lgkmcnt(0)
  s_cbranch_scc1 L_kred
  v_mov_b32 v48, 0
  v_mov_b32 v49, 0
  v_mov_b32 v50, 0
  v_mov_b32 v51, 0
  ds_read_b128 v[24:27], v9 offset:0
  ds_read_b128 v[28:31], v9 offset:64
  ds_read_b128 v[32:35], v9 offset:128
  ds_read_b128 v[36:39], v9 offset:192
  ds_read_b128 v[40:43], v9 offset:256
  ds_read_b128 v[44:47], v9 offset:320
  s_waitcnt vmcnt(25)
  s_waitcnt lgkmcnt(5)
  v_mfma_f32_16x16x32_bf16 v[48:51], v[24:27], v[56:59], v[48:51]
  s_waitcnt lgkmcnt(4)
  v_mfma_f32_16x16x32_bf16 v[48:51], v[28:31], v[60:63], v[48:51]
  s_waitcnt lgkmcnt(3)
  v_mfma_f32_16x16x32_bf16 v[48:51], v[32:35], v[64:67], v[48:51]
  s_waitcnt lgkmcnt(2)
  v_mfma_f32_16x16x32_bf16 v[48:51], v[36:39], v[68:71], v[48:51]
  s_waitcnt lgkmcnt(1)
  v_mfma_f32_16x16x32_bf16 v[48:51], v[40:43], v[72:75], v[48:51]
  s_waitcnt lgkmcnt(0)
  v_mfma_f32_16x16x32_bf16 v[48:51], v[44:47], v[76:79], v[48:51]
  s_nop 7
  s_nop 1
  s_mov_b32 s54, 0x3d93cd3a
  s_mov_b32 s55, 0x3fb8aa3b
  v_cvt_pk_bf16_f32 v24, v48, v49
  v_cvt_pk_bf16_f32 v25, v50, v51
  v_lshlrev_b32 v48, 16, v24
  v_and_b32 v49, 0xffff0000, v24
  v_lshlrev_b32 v50, 16, v25
  v_and_b32 v51, 0xffff0000, v25
  v_mul_f32 v48, s54, v48
  v_mul_f32 v49, s54, v49
  v_mul_f32 v50, s54, v50
  v_mul_f32 v51, s54, v51
  v_cvt_pk_bf16_f32 v24, v48, v49
  v_cvt_pk_bf16_f32 v25, v50, v51
  v_lshlrev_b32 v48, 16, v24
  v_and_b32 v49, 0xffff0000, v24
  v_lshlrev_b32 v50, 16, v25
  v_and_b32 v51, 0xffff0000, v25
  v_max_f32 v24, v48, v49
  v_max3_f32 v24, v24, v50, v51
  ds_swizzle_b32 v25, v24 offset:0x401F
  s_waitcnt lgkmcnt(0)
  v_max_f32 v24, v24, v25
  v_sub_f32 v48, v48, v24
  v_sub_f32 v49, v49, v24
  v_sub_f32 v50, v50, v24
  v_sub_f32 v51, v51, v24
  v_mul_f32 v48, s55, v48
  v_mul_f32 v49, s55, v49
  v_mul_f32 v50, s55, v50
  v_mul_f32 v51, s55, v51
  v_exp_f32 v48, v48
  v_exp_f32 v49, v49
  v_exp_f32 v50, v50
  v_exp_f32 v51, v51
  s_nop 0
  v_add_f32 v24, v48, v49
  v_add_f32 v25, v50, v51
  v_add_f32 v24, v24, v25
  ds_swizzle_b32 v25, v24 offset:0x401F
  s_waitcnt lgkmcnt(0)
  v_add_f32 v24, v24, v25
  v_rcp_f32 v24, v24
  s_nop 0
  v_mul_f32 v48, v48, v24
  v_mul_f32 v49, v49, v24
  v_mul_f32 v50, v50, v24
  v_mul_f32 v51, v51, v24
  v_cvt_pk_bf16_f32 v24, v48, v49
  v_cvt_pk_bf16_f32 v25, v50, v51
  ds_write_b64 v82, v[24:25]
  s_mov_b64 exec, 1
  ds_write_b32 v81, v83 offset:8
  s_mov_b64 exec, -1
  s_waitcnt lgkmcnt(0)
  s_branch L_chk
L_last:
  v_perm_b32 v24, v152, v148, s40
  v_perm_b32 v28, v152, v148, s41
  v_perm_b32 v25, v160, v156, s40
  v_perm_b32 v29, v160, v156, s41
  v_perm_b32 v26, v168, v164, s40
  v_perm_b32 v30, v168, v164, s41
  v_perm_b32 v27, v176, v172, s40
  v_perm_b32 v31, v176, v172, s41
  v_perm_b32 v32, v153, v149, s40
  v_perm_b32 v36, v153, v149, s41
  v_perm_b32 v33, v161, v157, s40
  v_perm_b32 v37, v161, v157, s41
  v_perm_b32 v34, v169, v165, s40
  v_perm_b32 v38, v169, v165, s41
  v_perm_b32 v35, v177, v173, s40
  v_perm_b32 v39, v177, v173, s41
  v_mfma_f32_16x16x32_bf16 v[116:119], v[12:15], v[24:27], v[116:119]
  v_mfma_f32_16x16x32_bf16 v[120:123], v[12:15], v[28:31], v[120:123]
  v_perm_b32 v40, v154, v150, s40
  v_perm_b32 v44, v154, v150, s41
  v_perm_b32 v41, v162, v158, s40
  v_perm_b32 v45, v162, v158, s41
  v_perm_b32 v42, v170, v166, s40
  v_perm_b32 v46, v170, v166, s41
  v_perm_b32 v43, v178, v174, s40
  v_perm_b32 v47, v178, v174, s41
  v_mfma_f32_16x16x32_bf16 v[124:127], v[12:15], v[32:35], v[124:127]
  v_mfma_f32_16x16x32_bf16 v[128:131], v[12:15], v[36:39], v[128:131]
  v_perm_b32 v48, v155, v151, s40
  v_perm_b32 v52, v155, v151, s41
  v_perm_b32 v49, v163, v159, s40
  v_perm_b32 v53, v163, v159, s41
  v_perm_b32 v50, v171, v167, s40
  v_perm_b32 v54, v171, v167, s41
  v_perm_b32 v51, v179, v175, s40
  v_perm_b32 v55, v179, v175, s41
  v_mfma_f32_16x16x32_bf16 v[132:135], v[12:15], v[40:43], v[132:135]
  v_mfma_f32_16x16x32_bf16 v[136:139], v[12:15], v[44:47], v[136:139]
  s_nop 1
  v_mfma_f32_16x16x32_bf16 v[140:143], v[12:15], v[48:51], v[140:143]
  v_mfma_f32_16x16x32_bf16 v[144:147], v[12:15], v[52:55], v[144:147]
  s_waitcnt vmcnt(8)
  v_perm_b32 v24, v184, v180, s40
  v_perm_b32 v28, v184, v180, s41
  v_perm_b32 v25, v192, v188, s40
  v_perm_b32 v29, v192, v188, s41
  v_perm_b32 v26, v200, v196, s40
  v_perm_b32 v30, v200, v196, s41
  v_perm_b32 v27, v208, v204, s40
  v_perm_b32 v31, v208, v204, s41
  v_perm_b32 v32, v185, v181, s40
  v_perm_b32 v36, v185, v181, s41
  v_perm_b32 v33, v193, v189, s40
  v_perm_b32 v37, v193, v189, s41
  v_perm_b32 v34, v201, v197, s40
  v_perm_b32 v38, v201, v197, s41
  v_perm_b32 v35, v209, v205, s40
  v_perm_b32 v39, v209, v205, s41
  v_mfma_f32_16x16x32_bf16 v[84:87], v[16:19], v[24:27], v[84:87]
  v_mfma_f32_16x16x32_bf16 v[88:91], v[16:19], v[28:31], v[88:91]
  v_perm_b32 v40, v186, v182, s40
  v_perm_b32 v44, v186, v182, s41
  v_perm_b32 v41, v194, v190, s40
  v_perm_b32 v45, v194, v190, s41
  v_perm_b32 v42, v202, v198, s40
  v_perm_b32 v46, v202, v198, s41
  v_perm_b32 v43, v210, v206, s40
  v_perm_b32 v47, v210, v206, s41
  v_mfma_f32_16x16x32_bf16 v[92:95], v[16:19], v[32:35], v[92:95]
  v_mfma_f32_16x16x32_bf16 v[96:99], v[16:19], v[36:39], v[96:99]
  v_perm_b32 v48, v187, v183, s40
  v_perm_b32 v52, v187, v183, s41
  v_perm_b32 v49, v195, v191, s40
  v_perm_b32 v53, v195, v191, s41
  v_perm_b32 v50, v203, v199, s40
  v_perm_b32 v54, v203, v199, s41
  v_perm_b32 v51, v211, v207, s40
  v_perm_b32 v55, v211, v207, s41
  v_mfma_f32_16x16x32_bf16 v[100:103], v[16:19], v[40:43], v[100:103]
  v_mfma_f32_16x16x32_bf16 v[104:107], v[16:19], v[44:47], v[104:107]
  s_nop 1
  v_mfma_f32_16x16x32_bf16 v[108:111], v[16:19], v[48:51], v[108:111]
  v_mfma_f32_16x16x32_bf16 v[112:115], v[16:19], v[52:55], v[112:115]
  s_waitcnt vmcnt(0)
  v_perm_b32 v24, v216, v212, s40
  v_perm_b32 v28, v216, v212, s41
  v_perm_b32 v25, v224, v220, s40
  v_perm_b32 v29, v224, v220, s41
  v_perm_b32 v26, v232, v228, s40
  v_perm_b32 v30, v232, v228, s41
  v_perm_b32 v27, v240, v236, s40
  v_perm_b32 v31, v240, v236, s41
  v_perm_b32 v32, v217, v213, s40
  v_perm_b32 v36, v217, v213, s41
  v_perm_b32 v33, v225, v221, s40
  v_perm_b32 v37, v225, v221, s41
  v_perm_b32 v34, v233, v229, s40
  v_perm_b32 v38, v233, v229, s41
  v_perm_b32 v35, v241, v237, s40
  v_perm_b32 v39, v241, v237, s41
  v_mfma_f32_16x16x32_bf16 v[84:87], v[20:23], v[24:27], v[84:87]
  v_mfma_f32_16x16x32_bf16 v[88:91], v[20:23], v[28:31], v[88:91]
  v_perm_b32 v40, v218, v214, s40
  v_perm_b32 v44, v218, v214, s41
  v_perm_b32 v41, v226, v222, s40
  v_perm_b32 v45, v226, v222, s41
  v_perm_b32 v42, v234, v230, s40
  v_perm_b32 v46, v234, v230, s41
  v_perm_b32 v43, v242, v238, s40
  v_perm_b32 v47, v242, v238, s41
  v_mfma_f32_16x16x32_bf16 v[92:95], v[20:23], v[32:35], v[92:95]
  v_mfma_f32_16x16x32_bf16 v[96:99], v[20:23], v[36:39], v[96:99]
  v_perm_b32 v48, v219, v215, s40
  v_perm_b32 v52, v219, v215, s41
  v_perm_b32 v49, v227, v223, s40
  v_perm_b32 v53, v227, v223, s41
  v_perm_b32 v50, v235, v231, s40
  v_perm_b32 v54, v235, v231, s41
  v_perm_b32 v51, v243, v239, s40
  v_perm_b32 v55, v243, v239, s41
  v_mfma_f32_16x16x32_bf16 v[100:103], v[20:23], v[40:43], v[100:103]
  v_mfma_f32_16x16x32_bf16 v[104:107], v[20:23], v[44:47], v[104:107]
  s_nop 1
  v_mfma_f32_16x16x32_bf16 v[108:111], v[20:23], v[48:51], v[108:111]
  v_mfma_f32_16x16x32_bf16 v[112:115], v[20:23], v[52:55], v[112:115]
  s_mov_b32 s37, s56
  s_cmp_eq_u32 s57, 0
  s_cbranch_scc1 L_dumpK
L_tail:
L_spin:
  ds_read_b32 v80, v81 offset:8
  s_waitcnt lgkmcnt(0)
  v_readfirstlane_b32 s46, v80
  s_nop 3
  s_cmp_lg_u32 s46, 0
  s_cbranch_scc1 L_go
  s_sleep 1
  s_branch L_spin
L_go:
  s_nop 7
  s_nop 1
  ds_write_b128 v5, v[84:87] offset:0
  ds_write_b128 v5, v[88:91] offset:416
  ds_write_b128 v5, v[92:95] offset:832
  ds_write_b128 v5, v[96:99] offset:1248
  ds_write_b128 v5, v[100:103] offset:1664
  ds_write_b128 v5, v[104:107] offset:2080
  ds_write_b128 v5, v[108:111] offset:2496
  ds_write_b128 v5, v[112:115] offset:2912
  s_mov_b64 exec, s[48:49]
  ds_write_b128 v6, v[116:119] offset:0
  ds_write_b128 v6, v[120:123] offset:416
  ds_write_b128 v6, v[124:127] offset:832
  ds_write_b128 v6, v[128:131] offset:1248
  ds_write_b128 v6, v[132:135] offset:1664
  ds_write_b128 v6, v[136:139] offset:2080
  ds_write_b128 v6, v[140:143] offset:2496
  ds_write_b128 v6, v[144:147] offset:2912
  s_mov_b64 exec, -1
  ds_read_b64 v[56:57], v82
  s_mov_b64 exec, 1
  ds_add_u32 v81, v83 offset:16
  s_mov_b64 exec, -1
  s_mul_i32 s46, s36, 96
  v_add_u32 v7, s46, v7
  v_add_u32 v11, s46, v11
L_vspin:
  ds_read_b32 v80, v81 offset:16
  s_waitcnt lgkmcnt(0)
  v_readfirstlane_b32 s46, v80
  s_nop 3
  s_cmp_lt_u32 s46, 4
  s_cbranch_scc1 L_vspin
  ds_read_b128 v[84:87], v7 offset:0
  ds_read_b128 v[88:91], v7 offset:6656
  ds_read_b128 v[92:95], v7 offset:13312
  ds_read_b128 v[96:99], v7 offset:19968
  ds_read_b128 v[100:103], v7 offset:26624
  ds_read_b128 v[104:107], v7 offset:33280
  ds_read_b128 v[108:111], v7 offset:39936
  ds_read_b128 v[112:115], v7 offset:46592
  ds_read_b128 v[116:119], v11 offset:0
  ds_read_b128 v[120:123], v11 offset:6656
  ds_read_b128 v[124:127], v11 offset:13312
  ds_read_b128 v[128:131], v11 offset:19968
  v_cndmask_b32 v58, 0, v56, s[50:51]
  v_cndmask_b32 v59, 0, v57, s[50:51]
  v_cndmask_b32 v60, 0, v56, s[52:53]
  v_cndmask_b32 v61, 0, v57, s[52:53]
  s_waitcnt lgkmcnt(10)
  v_add_f32 v84, v84, v88
  v_add_f32 v85, v85, v89
  v_add_f32 v86, v86, v90
  v_add_f32 v87, v87, v91
  s_waitcnt lgkmcnt(9)
  v_add_f32 v84, v84, v92
  v_add_f32 v85, v85, v93
  v_add_f32 v86, v86, v94
  v_add_f32 v87, v87, v95
  s_waitcnt lgkmcnt(8)
  v_add_f32 v84, v84, v96
  v_add_f32 v85, v85, v97
  v_add_f32 v86, v86, v98
  v_add_f32 v87, v87, v99
  s_waitcnt lgkmcnt(7)
  v_add_f32 v84, v84, v100
  v_add_f32 v85, v85, v101
  v_add_f32 v86, v86, v102
  v_add_f32 v87, v87, v103
  s_waitcnt lgkmcnt(6)
  v_add_f32 v84, v84, v104
  v_add_f32 v85, v85, v105
  v_add_f32 v86, v86, v106
  v_add_f32 v87, v87, v107
  s_waitcnt lgkmcnt(5)
  v_add_f32 v84, v84, v108
  v_add_f32 v85, v85, v109
  v_add_f32 v86, v86, v110
  v_add_f32 v87, v87, v111
  s_waitcnt lgkmcnt(4)
  v_add_f32 v84, v84, v112
  v_add_f32 v85, v85, v113
  v_add_f32 v86, v86, v114
  v_add_f32 v87, v87, v115
  v_cvt_pk_bf16_f32 v24, v84, v85
  v_cvt_pk_bf16_f32 v25, v86, v87
  s_waitcnt lgkmcnt(2)
  v_add_f32 v116, v116, v120
  v_add_f32 v117, v117, v121
  v_add_f32 v118, v118, v122
  v_add_f32 v119, v119, v123
  s_waitcnt lgkmcnt(1)
  v_add_f32 v116, v116, v124
  v_add_f32 v117, v117, v125
  v_add_f32 v118, v118, v126
  v_add_f32 v119, v119, v127
  s_waitcnt lgkmcnt(0)
  v_add_f32 v116, v116, v128
  v_add_f32 v117, v117, v129
  v_add_f32 v118, v118, v130
  v_add_f32 v119, v119, v131
  v_mfma_f32_16x16x16_bf16 v[32:35], v[24:25], v[58:59], 0
  v_mfma_f32_16x16x16_bf16 v[36:39], v[24:25], v[60:61], 0
  v_mov_b32 v120, v116
  v_mov_b32 v121, v117
  v_mov_b32 v122, v118
  v_mov_b32 v123, v119
  s_nop 1
  v_permlane32_swap_b32 v116, v120
  v_permlane32_swap_b32 v117, v121
  v_permlane32_swap_b32 v118, v122
  v_permlane32_swap_b32 v119, v123
  s_nop 1
  v_add_f32 v116, v116, v120
  v_add_f32 v117, v117, v121
  v_add_f32 v118, v118, v122
  v_add_f32 v119, v119, v123
  v_cvt_pk_bf16_f32 v26, v116, v117
  v_cvt_pk_bf16_f32 v27, v118, v119
  v_cvt_pk_bf16_f32 v44, v32, v33
  v_cvt_pk_bf16_f32 v45, v34, v35
  v_mfma_f32_16x16x16_bf16 v[40:43], v[26:27], v[58:59], 0
  v_cvt_pk_bf16_f32 v46, v36, v37
  v_cvt_pk_bf16_f32 v47, v38, v39
  buffer_store_dwordx2 v[44:45], v10, s[28:31], 0 offen
  buffer_store_dwordx2 v[46:47], v10, s[28:31], 0 offen offset:32
  s_nop 7
  v_cvt_pk_bf16_f32 v48, v40, v41
  v_cvt_pk_bf16_f32 v49, v42, v43
  buffer_store_dwordx2 v[48:49], v10, s[28:31], 0 offen offset:64
L_end:
  s_endpgm
.section .rodata,"a"
.p2align 6
.amdhsa_kernel standalone__low_rank_proj_linformer__sampling_kernel
  .amdhsa_next_free_vgpr 248
  .amdhsa_next_free_sgpr 102
  .amdhsa_accum_offset 248
  .amdhsa_group_segment_fixed_size 0
  .amdhsa_kernarg_size 64
  .amdhsa_user_sgpr_count 2
  .amdhsa_user_sgpr_kernarg_segment_ptr 1
  .amdhsa_system_sgpr_workgroup_id_x 1
.end_amdhsa_kernel
```
